```python
import torch

def _softmax(x, axis=-1):
    return torch.softmax(x, dim=axis)
def _gelu(x):
    return torch.nn.functional.gelu(x, approximate="tanh")
def _silu(x):
    return torch.nn.functional.silu(x)
def _sigmoid(x):
    return torch.sigmoid(x)
def _layernorm(x, axis=-1, eps=1e-5):
    m = x.mean(dim=axis, keepdim=True)
    v = x.var(dim=axis, keepdim=True, unbiased=False)
    return (x - m) / torch.sqrt(v + eps)
def _scatter_add(tgt, idx, src, axis=0):
    return tgt.clone().index_add_(axis, idx, src)
def _segment_sum(src, seg, n):
    out = torch.zeros((n,) + src.shape[1:], dtype=src.dtype)
    return out.index_add_(0, seg, src)
def _pad(x, pw):
    flat = tuple(v for pair in reversed(pw) for v in pair)
    return torch.nn.functional.pad(x, flat)

kernel_name = 'recurrent_scan__sliding_block_cached__dense_activation_gelu__decode'

def setup_inputs():

    _w = (lambda a: (lambda t: t.to(torch.bfloat16) if t.is_floating_point() else t)(torch.as_tensor(a)))
    def _A_setup():
        B, Sq, D = 8, 1, 512
        Hq, Hkv, Sk, Dh = 32, 8, 4096, 128
        assert Hq % Hkv == 0, (Hq, Hkv)
        return {
            "x": _w((lambda *s: torch.randn(*s, dtype=torch.bfloat16) * 0.05)(B, Sq, D)),
            "k_cache": _w((lambda *s: torch.randn(*s, dtype=torch.bfloat16) * 3.2)(B, Hkv, Sk, Dh)),
            "v_cache": _w((lambda *s: torch.randn(*s, dtype=torch.bfloat16) * 3.2)(B, Hkv, Sk, Dh)),
            "wq": _w((lambda *s: torch.randn(*s, dtype=torch.bfloat16) * 3.2)(D, Hq * Dh) * (D ** -0.5)),
            "wo": _w((lambda *s: torch.randn(*s, dtype=torch.bfloat16) * 3.2)(Hq * Dh, D) * ((Hq * Dh) ** -0.5)),
        }
    _A_in = _A_setup()

    def _B_setup():
        B, S, D, F = 8, 1, 512, 1792
        return {
            "x": _w((lambda *s: torch.randn(*s, dtype=torch.bfloat16) * 0.05)(B, S, D)),
            "w1": _w((lambda *s: torch.randn(*s, dtype=torch.bfloat16) * 3.2)(D, F) * (D ** -0.5)),
            "b1": _w((lambda *s: torch.randn(*s, dtype=torch.bfloat16) * 3.2)(F) * 0.01),
            "w2": _w((lambda *s: torch.randn(*s, dtype=torch.bfloat16) * 0.4)(F, D) * (F ** -0.5)),
            "b2": _w((lambda *s: torch.randn(*s, dtype=torch.bfloat16) * 0.4)(D) * 0.01),
        }
    _B_in = _B_setup()

    return {
        "A_x": _A_in["x"],
        "A_k_cache": _A_in["k_cache"],
        "A_v_cache": _A_in["v_cache"],
        "A_wq": _A_in["wq"],
        "A_wo": _A_in["wo"],
        "B_x": _B_in["x"],
        "B_w1": _B_in["w1"],
        "B_b1": _B_in["b1"],
        "B_w2": _B_in["w2"],
        "B_b2": _B_in["b2"],
    }

def reference(A_x, A_k_cache, A_v_cache, A_wq, A_wo, B_x, B_w1, B_b1, B_w2, B_b2):
    def _A_ref(x, k_cache, v_cache, wq, wo):
        B, Sq, D = x.shape
        Hq, Dh = 32, 128
        Hkv, Sk = k_cache.shape[1], k_cache.shape[2]
        W = min(4096, max(256, Sk // 4))
        rep = Hq // Hkv
        q = (lambda x, *d: x.permute(*d))((x @ wq).reshape(B, Sq, Hq, Dh), 0, 2, 1, 3)
        k = (lambda x, n, axis: torch.repeat_interleave(x, n, dim=axis))(k_cache[:, :, Sk - W:, :], rep, axis=1)
        v = (lambda x, n, axis: torch.repeat_interleave(x, n, dim=axis))(v_cache[:, :, Sk - W:, :], rep, axis=1)
        scores = torch.einsum("bhqd,bhkd->bhqk", q, k) * (Dh ** -0.5)
        p = _softmax(scores, axis=-1)
        o = torch.einsum("bhqk,bhkd->bhqd", p, v)
        return (lambda x, *d: x.permute(*d))(o, 0, 2, 1, 3).reshape(B, Sq, Hq * Dh) @ wo

    def _B_ref(x, w1, b1, w2, b2):
        h = torch.einsum("bsd,df->bsf", x, w1) + b1
        h = _gelu(h)
        return torch.einsum("bsf,fd->bsd", h, w2) + b2

    x = A_x
    xn = _layernorm(x, axis=-1)
    s = _A_ref(xn, A_k_cache, A_v_cache, A_wq, A_wo)
    g = _silu(_B_ref(xn, B_w1, B_b1, B_w2, B_b2))
    return x + s * g
```

```asm
; @launch grid=(256,1,1) block=(576,1,1) lds=28672
.amdgcn_target "amdgcn-amd-amdhsa--gfx950"
.text
.globl recurrent_scan__sliding_block_cached__dense_activation_gelu__decode_kernel
.p2align 8
.type recurrent_scan__sliding_block_cached__dense_activation_gelu__decode_kernel,@function
recurrent_scan__sliding_block_cached__dense_activation_gelu__decode_kernel:
    s_cmp_ge_u32 s2, 256
    s_cbranch_scc1 L_end
    s_load_dwordx16 s[4:19], s[0:1], 0
    s_load_dwordx8 s[20:27], s[0:1], 64
    s_load_dwordx2 s[28:29], s[0:1], 96

    v_and_b32 v1, 63, v0
    v_lshrrev_b32 v6, 6, v0
    v_and_b32 v2, 15, v1
    v_readfirstlane_b32 s30, v6
    v_lshrrev_b32 v3, 4, v1
    s_mov_b32 s58, 0x05040100
    s_mov_b32 s59, 0x07060302
    s_waitcnt lgkmcnt(0)

    s_mov_b32 s40, s28
    s_and_b32 s41, s29, 0xffff
    s_mov_b32 s42, 4194304
    s_mov_b32 s43, 0x20000

    s_mov_b32 s44, s26
    s_and_b32 s45, s27, 0xffff
    s_mov_b32 s46, 256
    s_mov_b32 s47, 0x20000

    s_cmp_eq_u32 s30, 8
    s_cbranch_scc1 L_service
    s_cmp_ge_u32 s2, 184
    s_cbranch_scc1 L_m_nop1load
    s_mov_b32 s52, 8192
    s_mov_b32 s53, 3584
    s_sub_u32 s54, s2, 128
    s_cmp_lt_u32 s2, 128
    s_cselect_b32 s32, s10, s16
    s_cselect_b32 s33, s11, s17
    s_cselect_b32 s31, s52, s53
    s_cselect_b32 s54, s2, s54
    s_and_b32 s33, s33, 0xffff
    s_lshl_b32 s34, s31, 9
    s_mov_b32 s35, 0x20000

    s_mov_b32 s36, s4
    s_and_b32 s37, s5, 0xffff
    s_mov_b32 s38, 8192
    s_mov_b32 s39, 0x20000

    v_lshlrev_b32 v5, 4, v1
    s_lshl_b32 s55, s30, 10
    v_add_u32 v5, s55, v5
    buffer_load_dwordx4 v[32:35], v5, s[36:39], 0 offen
    v_mul_lo_u32 v4, v3, s31
    v_lshlrev_b32 v4, 3, v4
    v_lshl_add_u32 v4, v2, 2, v4
    s_mul_i32 s55, s30, s31
    s_lshl_b32 s55, s55, 6
    s_lshl_b32 s56, s54, 6
    s_add_u32 s55, s55, s56
    v_add_u32 v4, s55, v4
    s_mov_b32 s56, 0
    s_mul_i32 s57, s31, 24

    buffer_load_dword v16, v4, s[32:35], s56 offen
    s_add_u32 s56, s56, s31
    buffer_load_dword v17, v4, s[32:35], s56 offen
    s_add_u32 s56, s56, s31
    buffer_load_dword v18, v4, s[32:35], s56 offen
    s_add_u32 s56, s56, s31
    buffer_load_dword v19, v4, s[32:35], s56 offen
    s_add_u32 s56, s56, s31
    buffer_load_dword v20, v4, s[32:35], s56 offen
    s_add_u32 s56, s56, s31
    buffer_load_dword v21, v4, s[32:35], s56 offen
    s_add_u32 s56, s56, s31
    buffer_load_dword v22, v4, s[32:35], s56 offen
    s_add_u32 s56, s56, s31
    buffer_load_dword v23, v4, s[32:35], s56 offen
    s_add_u32 s56, s56, s31
    s_add_u32 s56, s56, s57
    buffer_load_dword v24, v4, s[32:35], s56 offen
    s_add_u32 s56, s56, s31
    buffer_load_dword v25, v4, s[32:35], s56 offen
    s_add_u32 s56, s56, s31
    buffer_load_dword v26, v4, s[32:35], s56 offen
    s_add_u32 s56, s56, s31
    buffer_load_dword v27, v4, s[32:35], s56 offen
    s_add_u32 s56, s56, s31
    buffer_load_dword v28, v4, s[32:35], s56 offen
    s_add_u32 s56, s56, s31
    buffer_load_dword v29, v4, s[32:35], s56 offen
    s_add_u32 s56, s56, s31
    buffer_load_dword v30, v4, s[32:35], s56 offen
    s_add_u32 s56, s56, s31
    buffer_load_dword v31, v4, s[32:35], s56 offen
    s_add_u32 s56, s56, s31
L_m_nop1load:
    s_mov_b32 s76, s6
    s_and_b32 s77, s7, 0xffff
    s_mov_b32 s78, 67108864
    s_mov_b32 s79, 0x20000

    s_mov_b32 s64, s8
    s_and_b32 s65, s9, 0xffff
    s_mov_b32 s66, 67108864
    s_mov_b32 s67, 0x20000

    s_mov_b32 s68, s12
    s_and_b32 s69, s13, 0xffff
    s_mov_b32 s70, 4194304
    s_mov_b32 s71, 0x20000

    s_mov_b32 s72, s20
    s_and_b32 s73, s21, 0xffff
    s_mov_b32 s74, 1835008
    s_mov_b32 s75, 0x20000

    s_lshr_b32 s50, s2, 2
    s_and_b32 s51, s2, 3
    s_lshl_b32 s52, s50, 20
    s_lshl_b32 s53, s51, 16
    s_add_u32 s52, s52, s53
    s_lshl_b32 s53, s30, 13
    s_add_u32 s52, s52, s53
    s_add_u32 s52, s52, 0xC0000
    s_add_u32 s53, s52, 4096
    v_lshlrev_b32 v4, 8, v2
    v_lshl_add_u32 v4, v3, 4, v4
    v_lshlrev_b32 v6, 10, v3
    v_lshl_add_u32 v6, v2, 4, v6

    s_cmp_ge_u32 s2, 184
    s_cbranch_scc1 L_m_nop1
    s_waitcnt vmcnt(16)
    v_lshlrev_b32 v40, 16, v32
    v_and_b32 v41, 0xffff0000, v32
    v_lshlrev_b32 v42, 16, v33
    v_and_b32 v43, 0xffff0000, v33
    v_lshlrev_b32 v44, 16, v34
    v_and_b32 v45, 0xffff0000, v34
    v_lshlrev_b32 v46, 16, v35
    v_and_b32 v47, 0xffff0000, v35
    v_add_f32 v48, v40, v41
    v_add_f32 v48, v48, v42
    v_add_f32 v48, v48, v43
    v_add_f32 v48, v48, v44
    v_add_f32 v48, v48, v45
    v_add_f32 v48, v48, v46
    v_add_f32 v48, v48, v47
    s_nop 1
    v_add_f32_dpp v48, v48, v48 quad_perm:[1,0,3,2] row_mask:0xf bank_mask:0xf
    s_nop 1
    v_add_f32_dpp v48, v48, v48 quad_perm:[2,3,0,1] row_mask:0xf bank_mask:0xf
    s_nop 1
    v_add_f32_dpp v48, v48, v48 row_half_mirror row_mask:0xf bank_mask:0xf
    s_nop 1
    v_add_f32_dpp v48, v48, v48 row_mirror row_mask:0xf bank_mask:0xf
    s_nop 1
    v_readlane_b32 s60, v48, 0
    v_readlane_b32 s61, v48, 16
    v_readlane_b32 s62, v48, 32
    v_readlane_b32 s63, v48, 48
    s_nop 1
    v_mov_b32 v48, s60
    v_add_f32 v48, s61, v48
    v_add_f32 v48, s62, v48
    v_add_f32 v48, s63, v48

    v_mul_f32 v49, 0x3b000000, v48
    v_sub_f32 v50, v40, v49
    v_sub_f32 v51, v41, v49
    v_sub_f32 v52, v42, v49
    v_sub_f32 v53, v43, v49
    v_sub_f32 v54, v44, v49
    v_sub_f32 v55, v45, v49
    v_sub_f32 v56, v46, v49
    v_sub_f32 v57, v47, v49
    v_mul_f32 v48, v50, v50
    v_fmac_f32 v48, v51, v51
    v_fmac_f32 v48, v52, v52
    v_fmac_f32 v48, v53, v53
    v_fmac_f32 v48, v54, v54
    v_fmac_f32 v48, v55, v55
    v_fmac_f32 v48, v56, v56
    v_fmac_f32 v48, v57, v57
    s_nop 1
    v_add_f32_dpp v48, v48, v48 quad_perm:[1,0,3,2] row_mask:0xf bank_mask:0xf
    s_nop 1
    v_add_f32_dpp v48, v48, v48 quad_perm:[2,3,0,1] row_mask:0xf bank_mask:0xf
    s_nop 1
    v_add_f32_dpp v48, v48, v48 row_half_mirror row_mask:0xf bank_mask:0xf
    s_nop 1
    v_add_f32_dpp v48, v48, v48 row_mirror row_mask:0xf bank_mask:0xf
    s_nop 1
    v_readlane_b32 s60, v48, 0
    v_readlane_b32 s61, v48, 16
    v_readlane_b32 s62, v48, 32
    v_readlane_b32 s63, v48, 48
    s_nop 1
    v_mov_b32 v48, s60
    v_add_f32 v48, s61, v48
    v_add_f32 v48, s62, v48
    v_add_f32 v48, s63, v48

    v_mul_f32 v48, 0x3b000000, v48
    v_cvt_pk_bf16_f32 v49, v49, v49
    v_lshlrev_b32 v49, 16, v49
    v_cvt_pk_bf16_f32 v48, v48, v48
    v_lshlrev_b32 v48, 16, v48
    v_add_f32 v48, 0x3727c5ac, v48
    v_cvt_pk_bf16_f32 v48, v48, v48
    v_lshlrev_b32 v48, 16, v48
    v_sqrt_f32 v48, v48
    s_nop 0
    v_cvt_pk_bf16_f32 v48, v48, v48
    v_lshlrev_b32 v48, 16, v48
    v_rcp_f32 v58, v48
    s_nop 0
    v_sub_f32 v50, v40, v49
    v_cvt_pk_bf16_f32 v50, v50, v50
    v_lshlrev_b32 v50, 16, v50
    v_mul_f32 v59, v50, v58
    v_fma_f32 v40, -v59, v48, v50
    v_fma_f32 v50, v40, v58, v59

    v_sub_f32 v51, v41, v49
    v_cvt_pk_bf16_f32 v51, v51, v51
    v_lshlrev_b32 v51, 16, v51
    v_mul_f32 v59, v51, v58
    v_fma_f32 v41, -v59, v48, v51
    v_fma_f32 v51, v41, v58, v59

    v_sub_f32 v52, v42, v49
    v_cvt_pk_bf16_f32 v52, v52, v52
    v_lshlrev_b32 v52, 16, v52
    v_mul_f32 v59, v52, v58
    v_fma_f32 v42, -v59, v48, v52
    v_fma_f32 v52, v42, v58, v59

    v_sub_f32 v53, v43, v49
    v_cvt_pk_bf16_f32 v53, v53, v53
    v_lshlrev_b32 v53, 16, v53
    v_mul_f32 v59, v53, v58
    v_fma_f32 v43, -v59, v48, v53
    v_fma_f32 v53, v43, v58, v59

    v_sub_f32 v54, v44, v49
    v_cvt_pk_bf16_f32 v54, v54, v54
    v_lshlrev_b32 v54, 16, v54
    v_mul_f32 v59, v54, v58
    v_fma_f32 v44, -v59, v48, v54
    v_fma_f32 v54, v44, v58, v59

    v_sub_f32 v55, v45, v49
    v_cvt_pk_bf16_f32 v55, v55, v55
    v_lshlrev_b32 v55, 16, v55
    v_mul_f32 v59, v55, v58
    v_fma_f32 v45, -v59, v48, v55
    v_fma_f32 v55, v45, v58, v59

    v_sub_f32 v56, v46, v49
    v_cvt_pk_bf16_f32 v56, v56, v56
    v_lshlrev_b32 v56, 16, v56
    v_mul_f32 v59, v56, v58
    v_fma_f32 v46, -v59, v48, v56
    v_fma_f32 v56, v46, v58, v59

    v_sub_f32 v57, v47, v49
    v_cvt_pk_bf16_f32 v57, v57, v57
    v_lshlrev_b32 v57, 16, v57
    v_mul_f32 v59, v57, v58
    v_fma_f32 v47, -v59, v48, v57
    v_fma_f32 v57, v47, v58, v59

    v_cvt_pk_bf16_f32 v32, v50, v51
    v_cvt_pk_bf16_f32 v33, v52, v53
    v_cvt_pk_bf16_f32 v34, v54, v55
    v_cvt_pk_bf16_f32 v35, v56, v57
    v_lshlrev_b32 v7, 4, v1
    s_mul_i32 s55, s30, 1040
    v_add_u32 v7, s55, v7
    ds_write_b128 v7, v[32:35] offset:0
    v_and_b32 v58, 7, v2
    v_mul_u32_u24 v58, 1040, v58
    v_lshl_add_u32 v58, v3, 4, v58
    s_lshl_b32 s55, s30, 7
    v_add_u32 v58, s55, v58
    s_waitcnt lgkmcnt(0)
    s_barrier
    ds_read_b128 v[60:63], v58 offset:0
    ds_read_b128 v[64:67], v58 offset:64
    s_waitcnt vmcnt(0)

    v_perm_b32 v70, v17, v16, s58
    v_perm_b32 v74, v17, v16, s59
    v_perm_b32 v71, v19, v18, s58
    v_perm_b32 v75, v19, v18, s59
    v_perm_b32 v72, v21, v20, s58
    v_perm_b32 v76, v21, v20, s59
    v_perm_b32 v73, v23, v22, s58
    v_perm_b32 v77, v23, v22, s59
    v_perm_b32 v78, v25, v24, s58
    v_perm_b32 v82, v25, v24, s59
    v_perm_b32 v79, v27, v26, s58
    v_perm_b32 v83, v27, v26, s59
    v_perm_b32 v80, v29, v28, s58
    v_perm_b32 v84, v29, v28, s59
    v_perm_b32 v81, v31, v30, s58
    v_perm_b32 v85, v31, v30, s59
    v_mov_b32 v88, 0
    v_mov_b32 v89, 0
    v_mov_b32 v90, 0
    v_mov_b32 v91, 0
    v_mov_b32 v92, 0
    v_mov_b32 v93, 0
    v_mov_b32 v94, 0
    v_mov_b32 v95, 0
    s_waitcnt lgkmcnt(0)
    v_mfma_f32_16x16x32_bf16 v[88:91], v[60:63], v[70:73], v[88:91]
    v_mfma_f32_16x16x32_bf16 v[92:95], v[60:63], v[74:77], v[92:95]
    v_mfma_f32_16x16x32_bf16 v[88:91], v[64:67], v[78:81], v[88:91]
    v_mfma_f32_16x16x32_bf16 v[92:95], v[64:67], v[82:85], v[92:95]
    v_and_b32 v7, 1, v3
    v_lshlrev_b32 v7, 9, v7
    v_lshl_add_u32 v7, v2, 3, v7
    s_lshl_b32 s55, s30, 10
    s_add_u32 s55, s55, 8448
    v_add_u32 v7, s55, v7
    s_nop 7

    ds_write2_b32 v7, v88, v92 offset0:0 offset1:1
    ds_write2_b32 v7, v89, v93 offset0:32 offset1:33
    ds_write2_b32 v7, v90, v94 offset0:64 offset1:65
    ds_write2_b32 v7, v91, v95 offset0:96 offset1:97
    s_waitcnt lgkmcnt(0)
    s_barrier
    s_branch L_m_p1done
L_m_nop1:
    s_barrier
    s_barrier
L_m_p1done:

    s_barrier
    s_waitcnt vmcnt(15)
    buffer_load_dwordx4 v[104:107], v4, s[76:79], s52 offen offset:0
    s_waitcnt vmcnt(15)
    buffer_load_dwordx4 v[108:111], v4, s[76:79], s52 offen offset:64
    s_waitcnt vmcnt(15)
    buffer_load_dwordx4 v[112:115], v4, s[76:79], s52 offen offset:128
    s_waitcnt vmcnt(15)
    buffer_load_dwordx4 v[116:119], v4, s[76:79], s52 offen offset:192
    s_waitcnt vmcnt(15)
    buffer_load_dwordx4 v[120:123], v4, s[76:79], s53 offen offset:0
    s_waitcnt vmcnt(15)
    buffer_load_dwordx4 v[124:127], v4, s[76:79], s53 offen offset:64
    s_waitcnt vmcnt(15)
    buffer_load_dwordx4 v[128:131], v4, s[76:79], s53 offen offset:128
    s_waitcnt vmcnt(15)
    buffer_load_dwordx4 v[132:135], v4, s[76:79], s53 offen offset:192
    s_waitcnt vmcnt(15)
    buffer_load_dwordx4 v[136:139], v6, s[64:67], s52 offen offset:0
    s_waitcnt vmcnt(15)
    buffer_load_dwordx4 v[140:143], v6, s[64:67], s52 offen offset:256
    s_waitcnt vmcnt(15)
    buffer_load_dwordx4 v[144:147], v6, s[64:67], s52 offen offset:512
    s_waitcnt vmcnt(15)
    buffer_load_dwordx4 v[148:151], v6, s[64:67], s52 offen offset:768
    s_waitcnt vmcnt(15)
    buffer_load_dwordx4 v[152:155], v6, s[64:67], s53 offen offset:0
    s_waitcnt vmcnt(15)
    buffer_load_dwordx4 v[156:159], v6, s[64:67], s53 offen offset:256
    s_waitcnt vmcnt(15)
    buffer_load_dwordx4 v[160:163], v6, s[64:67], s53 offen offset:512
    s_waitcnt vmcnt(15)
    buffer_load_dwordx4 v[164:167], v6, s[64:67], s53 offen offset:768
    s_lshr_b32 s61, s2, 3
    s_lshl_b32 s61, s61, 7
    s_and_b32 s55, s30, 3
    s_lshl_b32 s55, s55, 5
    s_add_u32 s55, s55, s61
    s_lshl_b32 s55, s55, 10
    s_and_b32 s56, s2, 7
    s_lshl_b32 s56, s56, 7
    s_add_u32 s55, s55, s56
    s_lshr_b32 s56, s30, 2
    s_lshl_b32 s56, s56, 6
    s_add_u32 s55, s55, s56
    v_lshlrev_b32 v7, 13, v3
    v_lshl_add_u32 v7, v2, 2, v7

    buffer_load_dword v96, v7, s[68:71], s55 offen offset:0
    buffer_load_dword v97, v7, s[68:71], s55 offen offset:1024
    buffer_load_dword v98, v7, s[68:71], s55 offen offset:2048
    buffer_load_dword v99, v7, s[68:71], s55 offen offset:3072
    s_add_u32 s55, s55, 4096
    buffer_load_dword v100, v7, s[68:71], s55 offen offset:0
    buffer_load_dword v101, v7, s[68:71], s55 offen offset:1024
    buffer_load_dword v102, v7, s[68:71], s55 offen offset:2048
    buffer_load_dword v103, v7, s[68:71], s55 offen offset:3072
    s_cmp_lt_u32 s2, 144
    s_cbranch_scc1 L_m_now2load
    s_sub_u32 s61, s2, 144
    s_lshr_b32 s61, s61, 3
    s_lshl_b32 s61, s61, 7

    s_and_b32 s55, s30, 3
    s_lshl_b32 s55, s55, 5
    s_add_u32 s55, s55, s61
    s_lshl_b32 s55, s55, 10
    s_and_b32 s56, s2, 7
    s_lshl_b32 s56, s56, 7
    s_add_u32 s55, s55, s56
    s_lshr_b32 s56, s30, 2
    s_lshl_b32 s56, s56, 6
    s_add_u32 s55, s55, s56
    v_lshlrev_b32 v7, 13, v3
    v_lshl_add_u32 v7, v2, 2, v7

    buffer_load_dword v16, v7, s[72:75], s55 offen offset:0
    buffer_load_dword v17, v7, s[72:75], s55 offen offset:1024
    buffer_load_dword v18, v7, s[72:75], s55 offen offset:2048
    buffer_load_dword v19, v7, s[72:75], s55 offen offset:3072
    s_add_u32 s55, s55, 4096
    buffer_load_dword v20, v7, s[72:75], s55 offen offset:0
    buffer_load_dword v21, v7, s[72:75], s55 offen offset:1024
    buffer_load_dword v22, v7, s[72:75], s55 offen offset:2048
    buffer_load_dword v23, v7, s[72:75], s55 offen offset:3072
L_m_now2load:
    v_and_b32 v5, 3, v2
    v_lshlrev_b32 v5, 8, v5
    v_lshl_add_u32 v5, v3, 4, v5

    ds_read_b128 v[48:51], v5 offset:16640
    ds_read_b128 v[52:55], v5 offset:16704
    ds_read_b128 v[56:59], v5 offset:16768
    ds_read_b128 v[60:63], v5 offset:16832
    v_mov_b32 v40, 0
    v_mov_b32 v41, 0
    v_mov_b32 v42, 0
    v_mov_b32 v43, 0
    v_mov_b32 v44, 0
    v_mov_b32 v45, 0
    v_mov_b32 v46, 0
    v_mov_b32 v47, 0
    s_cmp_lt_u32 s2, 144
    s_cbranch_scc1 L_m_wk0
    s_waitcnt vmcnt(24) lgkmcnt(0)
    s_branch L_m_wk1
L_m_wk0:
    s_waitcnt vmcnt(16) lgkmcnt(0)
L_m_wk1:

    v_mfma_f32_16x16x32_bf16 v[40:43], v[104:107], v[48:51], v[40:43]
    v_mfma_f32_16x16x32_bf16 v[40:43], v[108:111], v[52:55], v[40:43]
    v_mfma_f32_16x16x32_bf16 v[40:43], v[112:115], v[56:59], v[40:43]
    v_mfma_f32_16x16x32_bf16 v[40:43], v[116:119], v[60:63], v[40:43]
    v_mfma_f32_16x16x32_bf16 v[44:47], v[120:123], v[48:51], v[44:47]
    v_mfma_f32_16x16x32_bf16 v[44:47], v[124:127], v[52:55], v[44:47]
    v_mfma_f32_16x16x32_bf16 v[44:47], v[128:131], v[56:59], v[44:47]
    v_mfma_f32_16x16x32_bf16 v[44:47], v[132:135], v[60:63], v[44:47]
    s_nop 7
    s_nop 1
    s_mov_b32 s55, 0x3db504f3
    v_cvt_pk_bf16_f32 v64, v40, v41
    v_lshlrev_b32 v40, 16, v64
    v_and_b32 v41, 0xffff0000, v64
    v_mul_f32 v40, s55, v40
    v_mul_f32 v41, s55, v41
    v_cvt_pk_bf16_f32 v64, v40, v41
    v_lshlrev_b32 v40, 16, v64
    v_and_b32 v41, 0xffff0000, v64

    v_cvt_pk_bf16_f32 v65, v42, v43
    v_lshlrev_b32 v42, 16, v65
    v_and_b32 v43, 0xffff0000, v65
    v_mul_f32 v42, s55, v42
    v_mul_f32 v43, s55, v43
    v_cvt_pk_bf16_f32 v65, v42, v43
    v_lshlrev_b32 v42, 16, v65
    v_and_b32 v43, 0xffff0000, v65

    v_cvt_pk_bf16_f32 v66, v44, v45
    v_lshlrev_b32 v44, 16, v66
    v_and_b32 v45, 0xffff0000, v66
    v_mul_f32 v44, s55, v44
    v_mul_f32 v45, s55, v45
    v_cvt_pk_bf16_f32 v66, v44, v45
    v_lshlrev_b32 v44, 16, v66
    v_and_b32 v45, 0xffff0000, v66

    v_cvt_pk_bf16_f32 v67, v46, v47
    v_lshlrev_b32 v46, 16, v67
    v_and_b32 v47, 0xffff0000, v67
    v_mul_f32 v46, s55, v46
    v_mul_f32 v47, s55, v47
    v_cvt_pk_bf16_f32 v67, v46, v47
    v_lshlrev_b32 v46, 16, v67
    v_and_b32 v47, 0xffff0000, v67

    v_max3_f32 v68, v40, v41, v42
    v_max3_f32 v68, v68, v43, v44
    v_max3_f32 v68, v68, v45, v46
    v_max_f32 v68, v68, v47

    v_mov_b32 v69, v68
    s_nop 1
    v_permlane16_swap_b32 v68, v69
    s_nop 1
    v_max_f32 v68, v68, v69
    v_mov_b32 v69, v68
    s_nop 1
    v_permlane32_swap_b32 v68, v69
    s_nop 1
    v_max_f32 v68, v68, v69

    v_and_b32 v70, 3, v2
    v_lshlrev_b32 v70, 5, v70
    s_lshl_b32 s55, s30, 2
    v_add_u32 v71, s55, v70
    ds_write_b32 v71, v68 offset:17664
    s_waitcnt lgkmcnt(0)
    s_barrier
    ds_read_b128 v[72:75], v70 offset:17664
    ds_read_b128 v[76:79], v70 offset:17680
    s_waitcnt lgkmcnt(0)
    v_max3_f32 v68, v72, v73, v74
    v_max3_f32 v68, v68, v75, v76
    v_max3_f32 v68, v68, v77, v78
    v_max_f32 v68, v68, v79
    s_mov_b32 s55, 0x3fb8aa3b

    v_sub_f32 v40, v40, v68
    v_mul_f32 v40, s55, v40
    v_exp_f32 v40, v40
    v_sub_f32 v41, v41, v68
    v_mul_f32 v41, s55, v41
    v_exp_f32 v41, v41
    v_sub_f32 v42, v42, v68
    v_mul_f32 v42, s55, v42
    v_exp_f32 v42, v42
    v_sub_f32 v43, v43, v68
    v_mul_f32 v43, s55, v43
    v_exp_f32 v43, v43
    v_sub_f32 v44, v44, v68
    v_mul_f32 v44, s55, v44
    v_exp_f32 v44, v44
    v_sub_f32 v45, v45, v68
    v_mul_f32 v45, s55, v45
    v_exp_f32 v45, v45
    v_sub_f32 v46, v46, v68
    v_mul_f32 v46, s55, v46
    v_exp_f32 v46, v46
    v_sub_f32 v47, v47, v68
    v_mul_f32 v47, s55, v47
    v_exp_f32 v47, v47
    s_nop 0
    v_add_f32 v84, v40, v41
    v_add_f32 v84, v84, v42
    v_add_f32 v84, v84, v43
    v_add_f32 v84, v84, v44
    v_add_f32 v84, v84, v45
    v_add_f32 v84, v84, v46
    v_add_f32 v84, v84, v47
    v_cvt_pk_bf16_f32 v80, v40, v41
    v_cvt_pk_bf16_f32 v81, v42, v43
    v_cvt_pk_bf16_f32 v82, v44, v45
    v_cvt_pk_bf16_f32 v83, v46, v47
    v_mov_b32 v85, v84
    s_nop 1
    v_permlane16_swap_b32 v84, v85
    s_nop 1
    v_add_f32 v84, v84, v85
    v_mov_b32 v85, v84
    s_nop 1
    v_permlane32_swap_b32 v84, v85
    s_nop 1
    v_add_f32 v84, v84, v85

    ds_write_b32 v71, v84 offset:17792
    s_cmp_lt_u32 s2, 144
    s_cbranch_scc1 L_m_wv0
    s_waitcnt vmcnt(16)
    s_branch L_m_wv1
L_m_wv0:
    s_waitcnt vmcnt(8)
L_m_wv1:

    v_perm_b32 v104, v140, v136, s58
    v_perm_b32 v105, v148, v144, s58
    v_perm_b32 v106, v156, v152, s58
    v_perm_b32 v107, v164, v160, s58
    v_perm_b32 v108, v140, v136, s59
    v_perm_b32 v109, v148, v144, s59
    v_perm_b32 v110, v156, v152, s59
    v_perm_b32 v111, v164, v160, s59
    v_perm_b32 v112, v141, v137, s58
    v_perm_b32 v113, v149, v145, s58
    v_perm_b32 v114, v157, v153, s58
    v_perm_b32 v115, v165, v161, s58
    v_perm_b32 v116, v141, v137, s59
    v_perm_b32 v117, v149, v145, s59
    v_perm_b32 v118, v157, v153, s59
    v_perm_b32 v119, v165, v161, s59
    v_perm_b32 v120, v142, v138, s58
    v_perm_b32 v121, v150, v146, s58
    v_perm_b32 v122, v158, v154, s58
    v_perm_b32 v123, v166, v162, s58
    v_perm_b32 v124, v142, v138, s59
    v_perm_b32 v125, v150, v146, s59
    v_perm_b32 v126, v158, v154, s59
    v_perm_b32 v127, v166, v162, s59
    v_perm_b32 v128, v143, v139, s58
    v_perm_b32 v129, v151, v147, s58
    v_perm_b32 v130, v159, v155, s58
    v_perm_b32 v131, v167, v163, s58
    v_perm_b32 v132, v143, v139, s59
    v_perm_b32 v133, v151, v147, s59
    v_perm_b32 v134, v159, v155, s59
    v_perm_b32 v135, v167, v163, s59
    s_nop 1
    v_mfma_f32_16x16x32_bf16 v[32:35], v[80:83], v[104:107], 0
    v_mfma_f32_16x16x32_bf16 v[36:39], v[80:83], v[108:111], 0
    v_mfma_f32_16x16x32_bf16 v[40:43], v[80:83], v[112:115], 0
    v_mfma_f32_16x16x32_bf16 v[44:47], v[80:83], v[116:119], 0
    v_mfma_f32_16x16x32_bf16 v[48:51], v[80:83], v[120:123], 0
    v_mfma_f32_16x16x32_bf16 v[52:55], v[80:83], v[124:127], 0
    v_mfma_f32_16x16x32_bf16 v[56:59], v[80:83], v[128:131], 0
    v_mfma_f32_16x16x32_bf16 v[60:63], v[80:83], v[132:135], 0
    s_nop 7
    s_nop 1
    v_mov_b32 v64, v32
    v_mov_b32 v65, v36
    v_mov_b32 v66, v40
    v_mov_b32 v67, v44
    v_mov_b32 v68, v48
    v_mov_b32 v69, v52
    v_mov_b32 v70, v56
    v_mov_b32 v71, v60
    v_mov_b32 v72, v33
    v_mov_b32 v73, v37
    v_mov_b32 v74, v41
    v_mov_b32 v75, v45
    v_mov_b32 v76, v49
    v_mov_b32 v77, v53
    v_mov_b32 v78, v57
    v_mov_b32 v79, v61
    v_mov_b32 v80, v34
    v_mov_b32 v81, v38
    v_mov_b32 v82, v42
    v_mov_b32 v83, v46
    v_mov_b32 v84, v50
    v_mov_b32 v85, v54
    v_mov_b32 v86, v58
    v_mov_b32 v87, v62
    v_mov_b32 v88, v35
    v_mov_b32 v89, v39
    v_mov_b32 v90, v43
    v_mov_b32 v91, v47
    v_mov_b32 v92, v51
    v_mov_b32 v93, v55
    v_mov_b32 v94, v59
    v_mov_b32 v95, v63
    v_lshlrev_b32 v24, 5, v2
    s_lshl_b32 s55, s30, 11
    v_add_u32 v24, s55, v24
    v_cmp_gt_u32 vcc, 16, v1
    s_and_saveexec_b64 s[56:57], vcc

    ds_write_b128 v24, v[64:67] offset:0
    ds_write_b128 v24, v[68:71] offset:16
    ds_write_b128 v24, v[72:75] offset:512
    ds_write_b128 v24, v[76:79] offset:528
    ds_write_b128 v24, v[80:83] offset:1024
    ds_write_b128 v24, v[84:87] offset:1040
    ds_write_b128 v24, v[88:91] offset:1536
    ds_write_b128 v24, v[92:95] offset:1552
    s_mov_b64 exec, s[56:57]
    s_waitcnt lgkmcnt(0)
    s_barrier
    s_cmp_ge_u32 s30, 2
    s_cbranch_scc1 L_m_ml
    v_lshlrev_b32 v25, 4, v0

    ds_read_b128 v[32:35], v25 offset:0
    ds_read_b128 v[36:39], v25 offset:2048
    ds_read_b128 v[40:43], v25 offset:4096
    ds_read_b128 v[44:47], v25 offset:6144
    ds_read_b128 v[48:51], v25 offset:8192
    ds_read_b128 v[52:55], v25 offset:10240
    ds_read_b128 v[56:59], v25 offset:12288
    ds_read_b128 v[60:63], v25 offset:14336
    s_waitcnt lgkmcnt(0)
    v_add_f32 v32, v32, v36
    v_add_f32 v33, v33, v37
    v_add_f32 v34, v34, v38
    v_add_f32 v35, v35, v39
    v_add_f32 v32, v32, v40
    v_add_f32 v33, v33, v41
    v_add_f32 v34, v34, v42
    v_add_f32 v35, v35, v43
    v_add_f32 v32, v32, v44
    v_add_f32 v33, v33, v45
    v_add_f32 v34, v34, v46
    v_add_f32 v35, v35, v47
    v_add_f32 v32, v32, v48
    v_add_f32 v33, v33, v49
    v_add_f32 v34, v34, v50
    v_add_f32 v35, v35, v51
    v_add_f32 v32, v32, v52
    v_add_f32 v33, v33, v53
    v_add_f32 v34, v34, v54
    v_add_f32 v35, v35, v55
    v_add_f32 v32, v32, v56
    v_add_f32 v33, v33, v57
    v_add_f32 v34, v34, v58
    v_add_f32 v35, v35, v59
    v_add_f32 v32, v32, v60
    v_add_f32 v33, v33, v61
    v_add_f32 v34, v34, v62
    v_add_f32 v35, v35, v63
    s_lshl_b32 s55, s2, 11
    s_add_u32 s55, s55, 262144
    buffer_store_dwordx4 v[32:35], v25, s[40:43], s55 offen sc0 sc1
    s_branch L_m_pub
L_m_ml:
    s_cmp_lg_u32 s30, 2
    s_cbranch_scc1 L_m_pub
    v_and_b32 v28, 3, v1
    v_lshlrev_b32 v28, 5, v28
    ds_read_b128 v[32:35], v28 offset:17664
    ds_read_b128 v[36:39], v28 offset:17680
    ds_read_b128 v[40:43], v28 offset:17792
    ds_read_b128 v[44:47], v28 offset:17808
    s_waitcnt lgkmcnt(0)
    v_max3_f32 v26, v32, v33, v34
    v_max3_f32 v26, v26, v35, v36
    v_max3_f32 v26, v26, v37, v38
    v_max_f32 v26, v26, v39
    v_add_f32 v27, v40, v41
    v_add_f32 v27, v27, v42
    v_add_f32 v27, v27, v43
    v_add_f32 v27, v27, v44
    v_add_f32 v27, v27, v45
    v_add_f32 v27, v27, v46
    v_add_f32 v27, v27, v47
    v_lshlrev_b32 v28, 3, v1
    s_lshl_b32 s55, s2, 5
    s_add_u32 s55, s55, 131072
    v_cmp_gt_u32 vcc, 4, v1
    s_and_saveexec_b64 s[56:57], vcc
    buffer_store_dwordx2 v[26:27], v28, s[40:43], s55 offen sc0 sc1
    s_mov_b64 exec, s[56:57]
L_m_pub:

    v_lshlrev_b32 v13, 8, v2
    v_add_u32 v13, 200704, v13
    s_mov_b32 s63, 2000000
L_m_ib:
    buffer_load_dword v12, v13, s[40:43], 0 offen sc0 sc1
    s_waitcnt vmcnt(0)
    v_cmp_gt_u32 vcc, 16, v12
    s_cmp_eq_u64 vcc, 0
    s_cbranch_scc1 L_m_ibd
    s_sleep 1
    s_sub_u32 s63, s63, 1
    s_cmp_lg_u32 s63, 0
    s_cbranch_scc1 L_m_ib
L_m_ibd:

    s_and_b32 s54, s2, 7
    s_cmp_lt_u32 s2, 144
    s_cbranch_scc1 L_m_now2
    s_sub_u32 s61, s2, 144
    s_lshr_b32 s61, s61, 3
    v_and_b32 v5, 7, v2
    v_mul_u32_u24 v5, 3584, v5
    v_lshl_add_u32 v5, v3, 4, v5
    s_lshl_b32 s60, s61, 8
    s_and_b32 s56, s30, 3
    s_lshl_b32 s56, s56, 6
    s_add_u32 s60, s60, s56
    s_add_u32 s60, s60, 65536

    s_mov_b32 s63, 2000000
L_pd_h:
    buffer_load_dwordx4 v[60:63], v5, s[40:43], s60 offen sc0 sc1
    s_waitcnt vmcnt(0)
    v_max_u32 v12, v60, v61
    v_max3_u32 v12, v12, v62, v63
    v_cmp_eq_u32 vcc, -1, v12
    s_cmp_eq_u64 vcc, 0
    s_cbranch_scc1 L_pdd_h
    s_sleep 1
    s_sub_u32 s63, s63, 1
    s_cmp_lg_u32 s63, 0
    s_cbranch_scc1 L_pd_h
L_pdd_h:

    v_perm_b32 v70, v17, v16, s58
    v_perm_b32 v74, v17, v16, s59
    v_perm_b32 v71, v19, v18, s58
    v_perm_b32 v75, v19, v18, s59
    v_perm_b32 v72, v21, v20, s58
    v_perm_b32 v76, v21, v20, s59
    v_perm_b32 v73, v23, v22, s58
    v_perm_b32 v77, v23, v22, s59
    v_mov_b32 v88, 0
    v_mov_b32 v89, 0
    v_mov_b32 v90, 0
    v_mov_b32 v91, 0
    v_mov_b32 v92, 0
    v_mov_b32 v93, 0
    v_mov_b32 v94, 0
    v_mov_b32 v95, 0

    v_mfma_f32_16x16x32_bf16 v[88:91], v[60:63], v[70:73], v[88:91]
    v_mfma_f32_16x16x32_bf16 v[92:95], v[60:63], v[74:77], v[92:95]
    v_and_b32 v7, 1, v3
    v_lshlrev_b32 v7, 10, v7
    v_lshl_add_u32 v7, v2, 3, v7
    s_and_b32 s55, s30, 3
    s_lshl_b32 s55, s55, 11
    s_lshr_b32 s56, s30, 2
    s_lshl_b32 s56, s56, 7
    s_add_u32 s55, s55, s56
    s_add_u32 s55, s55, 20480
    v_add_u32 v7, s55, v7
    s_nop 7

    ds_write2_b32 v7, v88, v92 offset0:0 offset1:1
    ds_write2_b32 v7, v89, v93 offset0:64 offset1:65
    ds_write2_b32 v7, v90, v94 offset0:128 offset1:129
    ds_write2_b32 v7, v91, v95 offset0:192 offset1:193
    s_waitcnt lgkmcnt(0)
    s_barrier
    v_lshlrev_b32 v7, 2, v0
    ds_read_b32 v64, v7 offset:20480
    ds_read_b32 v65, v7 offset:22528
    ds_read_b32 v66, v7 offset:24576
    ds_read_b32 v67, v7 offset:26624
    v_lshlrev_b32 v68, 2, v1
    s_lshl_b32 s55, s54, 3
    s_add_u32 s55, s55, s30
    s_lshl_b32 s55, s55, 4
    s_add_u32 s55, s55, s61
    s_lshl_b32 s55, s55, 8
    s_add_u32 s55, s55, 1310720
    s_waitcnt lgkmcnt(0)
    v_add_f32 v64, v64, v65
    v_add_f32 v66, v66, v67
    v_add_f32 v64, v64, v66
    buffer_store_dword v64, v68, s[40:43], s55 offen sc0 sc1

L_m_now2:
    s_lshr_b32 s50, s2, 3
    s_lshl_b32 s55, s30, 5
    s_lshr_b32 s56, s50, 2
    s_lshl_b32 s56, s56, 2
    s_add_u32 s55, s55, s56
    s_and_b32 s57, s50, 3
    s_lshl_b32 s60, s55, 11
    s_lshl_b32 s61, s57, 9
    s_add_u32 s60, s60, s61
    s_add_u32 s60, s60, 262144
    s_add_u32 s62, s60, 4096
    s_lshl_b32 s61, s55, 5
    s_lshl_b32 s56, s57, 3
    s_add_u32 s61, s61, s56
    s_add_u32 s61, s61, 131072
    v_lshlrev_b32 v5, 3, v1
    v_mov_b32 v6, 0

    s_mov_b32 s63, 2000000
L_pd_o:
    buffer_load_dwordx2 v[32:33], v5, s[40:43], s60 offen offset:0 sc0 sc1
    buffer_load_dwordx2 v[34:35], v5, s[40:43], s60 offen offset:2048 sc0 sc1
    buffer_load_dwordx2 v[36:37], v5, s[40:43], s62 offen offset:0 sc0 sc1
    buffer_load_dwordx2 v[38:39], v5, s[40:43], s62 offen offset:2048 sc0 sc1
    buffer_load_dwordx2 v[40:41], v6, s[40:43], s61 offen offset:0 sc0 sc1
    buffer_load_dwordx2 v[42:43], v6, s[40:43], s61 offen offset:32 sc0 sc1
    buffer_load_dwordx2 v[44:45], v6, s[40:43], s61 offen offset:64 sc0 sc1
    buffer_load_dwordx2 v[46:47], v6, s[40:43], s61 offen offset:96 sc0 sc1
    s_waitcnt vmcnt(0)
    v_max_u32 v12, v32, v33
    v_max3_u32 v12, v12, v34, v35
    v_max3_u32 v12, v12, v36, v37
    v_max3_u32 v12, v12, v38, v39
    v_max3_u32 v12, v12, v40, v41
    v_max3_u32 v12, v12, v42, v43
    v_max3_u32 v12, v12, v44, v45
    v_max3_u32 v12, v12, v46, v47
    v_cmp_eq_u32 vcc, -1, v12
    s_cmp_eq_u64 vcc, 0
    s_cbranch_scc1 L_pdd_o
    s_sleep 1
    s_sub_u32 s63, s63, 1
    s_cmp_lg_u32 s63, 0
    s_cbranch_scc1 L_pd_o
L_pdd_o:

    v_max3_f32 v48, v40, v42, v44
    v_max_f32 v48, v48, v46
    s_mov_b32 s55, 0x3fb8aa3b

    v_sub_f32 v50, v40, v48
    v_mul_f32 v50, s55, v50
    v_exp_f32 v50, v50
    v_sub_f32 v51, v42, v48
    v_mul_f32 v51, s55, v51
    v_exp_f32 v51, v51
    v_sub_f32 v52, v44, v48
    v_mul_f32 v52, s55, v52
    v_exp_f32 v52, v52
    v_sub_f32 v53, v46, v48
    v_mul_f32 v53, s55, v53
    v_exp_f32 v53, v53
    s_nop 0
    v_mul_f32 v49, v50, v41
    v_fmac_f32 v49, v51, v43
    v_fmac_f32 v49, v52, v45
    v_fmac_f32 v49, v53, v47
    v_mul_f32 v54, v50, v32
    v_mul_f32 v55, v50, v33
    v_fmac_f32 v54, v51, v34
    v_fmac_f32 v55, v51, v35
    v_fmac_f32 v54, v52, v36
    v_fmac_f32 v55, v52, v37
    v_fmac_f32 v54, v53, v38
    v_fmac_f32 v55, v53, v39
    v_rcp_f32 v49, v49
    s_nop 0
    v_mul_f32 v54, v54, v49
    v_mul_f32 v55, v55, v49
    v_cvt_pk_bf16_f32 v54, v54, v55
    s_mul_i32 s55, s30, 272
    v_lshlrev_b32 v5, 2, v1
    v_add_u32 v5, s55, v5
    ds_write_b32 v5, v54 offset:17920
    v_and_b32 v5, 7, v2
    v_mul_u32_u24 v5, 272, v5
    v_lshl_add_u32 v5, v3, 4, v5
    s_and_b32 s55, s30, 3
    s_lshl_b32 s55, s55, 6
    v_add_u32 v5, s55, v5
    s_waitcnt lgkmcnt(0)
    s_barrier
    ds_read_b128 v[60:63], v5 offset:17920

    v_perm_b32 v70, v97, v96, s58
    v_perm_b32 v74, v97, v96, s59
    v_perm_b32 v71, v99, v98, s58
    v_perm_b32 v75, v99, v98, s59
    v_perm_b32 v72, v101, v100, s58
    v_perm_b32 v76, v101, v100, s59
    v_perm_b32 v73, v103, v102, s58
    v_perm_b32 v77, v103, v102, s59
    v_mov_b32 v88, 0
    v_mov_b32 v89, 0
    v_mov_b32 v90, 0
    v_mov_b32 v91, 0
    v_mov_b32 v92, 0
    v_mov_b32 v93, 0
    v_mov_b32 v94, 0
    v_mov_b32 v95, 0
    s_waitcnt vmcnt(0) lgkmcnt(0)
    v_mfma_f32_16x16x32_bf16 v[88:91], v[60:63], v[70:73], v[88:91]
    v_mfma_f32_16x16x32_bf16 v[92:95], v[60:63], v[74:77], v[92:95]
    v_and_b32 v7, 1, v3
    v_lshlrev_b32 v7, 10, v7
    v_lshl_add_u32 v7, v2, 3, v7
    s_and_b32 s55, s30, 3
    s_lshl_b32 s55, s55, 11
    s_lshr_b32 s56, s30, 2
    s_lshl_b32 s56, s56, 7
    s_add_u32 s55, s55, s56
    s_add_u32 s55, s55, 20480
    v_add_u32 v7, s55, v7
    s_nop 7

    ds_write2_b32 v7, v88, v92 offset0:0 offset1:1
    ds_write2_b32 v7, v89, v93 offset0:64 offset1:65
    ds_write2_b32 v7, v90, v94 offset0:128 offset1:129
    ds_write2_b32 v7, v91, v95 offset0:192 offset1:193
    s_waitcnt lgkmcnt(0)
    s_barrier
    v_lshlrev_b32 v7, 2, v0
    ds_read_b32 v64, v7 offset:20480
    ds_read_b32 v65, v7 offset:22528
    ds_read_b32 v66, v7 offset:24576
    ds_read_b32 v67, v7 offset:26624
    v_lshlrev_b32 v68, 2, v1
    s_lshl_b32 s55, s54, 3
    s_add_u32 s55, s55, s30
    s_lshl_b32 s55, s55, 5
    s_add_u32 s55, s55, s50
    s_lshl_b32 s55, s55, 8
    s_add_u32 s55, s55, 786432
    s_waitcnt lgkmcnt(0)
    v_add_f32 v64, v64, v65
    v_add_f32 v66, v66, v67
    v_add_f32 v64, v64, v66
    buffer_store_dword v64, v68, s[40:43], s55 offen sc0 sc1

    s_cmp_lg_u32 s30, 0
    s_cbranch_scc1 L_end
    s_cmp_ge_u32 s2, 64
    s_cbranch_scc1 L_m_fin
    s_lshr_b32 s50, s2, 3
    s_lshl_b32 s55, s54, 3
    s_add_u32 s55, s55, s50
    s_lshl_b32 s60, s55, 13
    s_add_u32 s60, s60, 786432
    s_add_u32 s61, s60, 4096
    s_lshl_b32 s62, s55, 12
    s_add_u32 s62, s62, 1310720
    v_lshlrev_b32 v5, 4, v1
    v_mov_b32 v60, 0
    v_mov_b32 v61, 0
    v_mov_b32 v62, 0
    v_mov_b32 v63, 0

    s_mov_b32 s32, s4
    s_and_b32 s33, s5, 0xffff
    s_mov_b32 s34, 8192
    s_mov_b32 s35, 0x20000

    s_mov_b32 s36, s22
    s_and_b32 s37, s23, 0xffff
    s_mov_b32 s38, 1024
    s_mov_b32 s39, 0x20000

    s_mov_b32 s76, s24
    s_and_b32 s77, s25, 0xffff
    s_mov_b32 s78, 8192
    s_mov_b32 s79, 0x20000

    v_lshlrev_b32 v6, 3, v2
    s_lshl_b32 s57, s54, 7
    s_lshl_b32 s51, s50, 10
    s_add_u32 s51, s51, s57
    buffer_load_dwordx2 v[64:65], v6, s[32:35], s51 offen
    buffer_load_dwordx2 v[66:67], v6, s[36:39], s57 offen

    s_mov_b32 s63, 2000000
L_pd_f:
    buffer_load_dwordx4 v[16:19], v5, s[40:43], s60 offen offset:0 sc0 sc1
    buffer_load_dwordx4 v[20:23], v5, s[40:43], s60 offen offset:1024 sc0 sc1
    buffer_load_dwordx4 v[24:27], v5, s[40:43], s60 offen offset:2048 sc0 sc1
    buffer_load_dwordx4 v[28:31], v5, s[40:43], s60 offen offset:3072 sc0 sc1
    buffer_load_dwordx4 v[32:35], v5, s[40:43], s61 offen offset:0 sc0 sc1
    buffer_load_dwordx4 v[36:39], v5, s[40:43], s61 offen offset:1024 sc0 sc1
    buffer_load_dwordx4 v[40:43], v5, s[40:43], s61 offen offset:2048 sc0 sc1
    buffer_load_dwordx4 v[44:47], v5, s[40:43], s61 offen offset:3072 sc0 sc1
    buffer_load_dwordx4 v[48:51], v5, s[40:43], s62 offen offset:0 sc0 sc1
    buffer_load_dwordx4 v[52:55], v5, s[40:43], s62 offen offset:1024 sc0 sc1
    buffer_load_dwordx4 v[56:59], v5, s[40:43], s62 offen offset:2048 sc0 sc1
    s_mov_b32 exec_hi, 0
    buffer_load_dwordx4 v[60:63], v5, s[40:43], s62 offen offset:3072 sc0 sc1
    s_mov_b64 exec, -1
    s_waitcnt vmcnt(0)
    v_max_u32 v12, v16, v17
    v_max3_u32 v12, v12, v18, v19
    v_max3_u32 v12, v12, v20, v21
    v_max3_u32 v12, v12, v22, v23
    v_max3_u32 v12, v12, v24, v25
    v_max3_u32 v12, v12, v26, v27
    v_max3_u32 v12, v12, v28, v29
    v_max3_u32 v12, v12, v30, v31
    v_max3_u32 v12, v12, v32, v33
    v_max3_u32 v12, v12, v34, v35
    v_max3_u32 v12, v12, v36, v37
    v_max3_u32 v12, v12, v38, v39
    v_max3_u32 v12, v12, v40, v41
    v_max3_u32 v12, v12, v42, v43
    v_max3_u32 v12, v12, v44, v45
    v_max3_u32 v12, v12, v46, v47
    v_max3_u32 v12, v12, v48, v49
    v_max3_u32 v12, v12, v50, v51
    v_max3_u32 v12, v12, v52, v53
    v_max3_u32 v12, v12, v54, v55
    v_max3_u32 v12, v12, v56, v57
    v_max3_u32 v12, v12, v58, v59
    v_max3_u32 v12, v12, v60, v61
    v_max3_u32 v12, v12, v62, v63
    v_cmp_eq_u32 vcc, -1, v12
    s_cmp_eq_u64 vcc, 0
    s_cbranch_scc1 L_pdd_f
    s_sleep 1
    s_sub_u32 s63, s63, 1
    s_cmp_lg_u32 s63, 0
    s_cbranch_scc1 L_pd_f
L_pdd_f:

    v_add_f32 v16, v16, v20
    v_add_f32 v17, v17, v21
    v_add_f32 v18, v18, v22
    v_add_f32 v19, v19, v23
    v_add_f32 v16, v16, v24
    v_add_f32 v17, v17, v25
    v_add_f32 v18, v18, v26
    v_add_f32 v19, v19, v27
    v_add_f32 v16, v16, v28
    v_add_f32 v17, v17, v29
    v_add_f32 v18, v18, v30
    v_add_f32 v19, v19, v31
    v_add_f32 v16, v16, v32
    v_add_f32 v17, v17, v33
    v_add_f32 v18, v18, v34
    v_add_f32 v19, v19, v35
    v_add_f32 v16, v16, v36
    v_add_f32 v17, v17, v37
    v_add_f32 v18, v18, v38
    v_add_f32 v19, v19, v39
    v_add_f32 v16, v16, v40
    v_add_f32 v17, v17, v41
    v_add_f32 v18, v18, v42
    v_add_f32 v19, v19, v43
    v_add_f32 v16, v16, v44
    v_add_f32 v17, v17, v45
    v_add_f32 v18, v18, v46
    v_add_f32 v19, v19, v47
    v_add_f32 v48, v48, v52
    v_add_f32 v49, v49, v53
    v_add_f32 v50, v50, v54
    v_add_f32 v51, v51, v55
    v_add_f32 v48, v48, v56
    v_add_f32 v49, v49, v57
    v_add_f32 v50, v50, v58
    v_add_f32 v51, v51, v59
    v_add_f32 v48, v48, v60
    v_add_f32 v49, v49, v61
    v_add_f32 v50, v50, v62
    v_add_f32 v51, v51, v63
    v_mov_b32 v12, v16
    s_nop 1
    v_permlane16_swap_b32 v16, v12
    s_nop 1
    v_add_f32 v16, v16, v12
    v_mov_b32 v12, v16
    s_nop 1
    v_permlane32_swap_b32 v16, v12
    s_nop 1
    v_add_f32 v16, v16, v12

    v_mov_b32 v12, v48
    s_nop 1
    v_permlane16_swap_b32 v48, v12
    s_nop 1
    v_add_f32 v48, v48, v12
    v_mov_b32 v12, v48
    s_nop 1
    v_permlane32_swap_b32 v48, v12
    s_nop 1
    v_add_f32 v48, v48, v12

    v_mov_b32 v12, v17
    s_nop 1
    v_permlane16_swap_b32 v17, v12
    s_nop 1
    v_add_f32 v17, v17, v12
    v_mov_b32 v12, v17
    s_nop 1
    v_permlane32_swap_b32 v17, v12
    s_nop 1
    v_add_f32 v17, v17, v12

    v_mov_b32 v12, v49
    s_nop 1
    v_permlane16_swap_b32 v49, v12
    s_nop 1
    v_add_f32 v49, v49, v12
    v_mov_b32 v12, v49
    s_nop 1
    v_permlane32_swap_b32 v49, v12
    s_nop 1
    v_add_f32 v49, v49, v12

    v_mov_b32 v12, v18
    s_nop 1
    v_permlane16_swap_b32 v18, v12
    s_nop 1
    v_add_f32 v18, v18, v12
    v_mov_b32 v12, v18
    s_nop 1
    v_permlane32_swap_b32 v18, v12
    s_nop 1
    v_add_f32 v18, v18, v12

    v_mov_b32 v12, v50
    s_nop 1
    v_permlane16_swap_b32 v50, v12
    s_nop 1
    v_add_f32 v50, v50, v12
    v_mov_b32 v12, v50
    s_nop 1
    v_permlane32_swap_b32 v50, v12
    s_nop 1
    v_add_f32 v50, v50, v12

    v_mov_b32 v12, v19
    s_nop 1
    v_permlane16_swap_b32 v19, v12
    s_nop 1
    v_add_f32 v19, v19, v12
    v_mov_b32 v12, v19
    s_nop 1
    v_permlane32_swap_b32 v19, v12
    s_nop 1
    v_add_f32 v19, v19, v12

    v_mov_b32 v12, v51
    s_nop 1
    v_permlane16_swap_b32 v51, v12
    s_nop 1
    v_add_f32 v51, v51, v12
    v_mov_b32 v12, v51
    s_nop 1
    v_permlane32_swap_b32 v51, v12
    s_nop 1
    v_add_f32 v51, v51, v12

    v_cvt_pk_bf16_f32 v40, v16, v17
    v_lshlrev_b32 v41, 16, v40
    v_and_b32 v42, 0xffff0000, v40
    v_cvt_pk_bf16_f32 v40, v48, v49
    v_lshlrev_b32 v43, 16, v40
    v_and_b32 v44, 0xffff0000, v40
    v_lshlrev_b32 v45, 16, v66
    v_and_b32 v46, 0xffff0000, v66
    v_add_f32 v43, v43, v45
    v_add_f32 v44, v44, v46
    v_cvt_pk_bf16_f32 v40, v43, v44
    v_lshlrev_b32 v43, 16, v40
    v_and_b32 v44, 0xffff0000, v40

    v_mul_f32 v45, 0xbfb8aa3b, v43
    v_exp_f32 v45, v45
    s_nop 0
    v_add_f32 v45, 1.0, v45
    v_rcp_f32 v45, v45
    s_nop 0
    v_mul_f32 v43, v43, v45

    v_mul_f32 v45, 0xbfb8aa3b, v44
    v_exp_f32 v45, v45
    s_nop 0
    v_add_f32 v45, 1.0, v45
    v_rcp_f32 v45, v45
    s_nop 0
    v_mul_f32 v44, v44, v45

    v_cvt_pk_bf16_f32 v40, v43, v44
    v_lshlrev_b32 v43, 16, v40
    v_and_b32 v44, 0xffff0000, v40
    v_mul_f32 v41, v41, v43
    v_mul_f32 v42, v42, v44
    v_cvt_pk_bf16_f32 v40, v41, v42
    v_lshlrev_b32 v41, 16, v40
    v_and_b32 v42, 0xffff0000, v40
    v_lshlrev_b32 v45, 16, v64
    v_and_b32 v46, 0xffff0000, v64
    v_add_f32 v41, v41, v45
    v_add_f32 v42, v42, v46
    v_cvt_pk_bf16_f32 v68, v41, v42

    v_cvt_pk_bf16_f32 v40, v18, v19
    v_lshlrev_b32 v41, 16, v40
    v_and_b32 v42, 0xffff0000, v40
    v_cvt_pk_bf16_f32 v40, v50, v51
    v_lshlrev_b32 v43, 16, v40
    v_and_b32 v44, 0xffff0000, v40
    v_lshlrev_b32 v45, 16, v67
    v_and_b32 v46, 0xffff0000, v67
    v_add_f32 v43, v43, v45
    v_add_f32 v44, v44, v46
    v_cvt_pk_bf16_f32 v40, v43, v44
    v_lshlrev_b32 v43, 16, v40
    v_and_b32 v44, 0xffff0000, v40

    v_mul_f32 v45, 0xbfb8aa3b, v43
    v_exp_f32 v45, v45
    s_nop 0
    v_add_f32 v45, 1.0, v45
    v_rcp_f32 v45, v45
    s_nop 0
    v_mul_f32 v43, v43, v45

    v_mul_f32 v45, 0xbfb8aa3b, v44
    v_exp_f32 v45, v45
    s_nop 0
    v_add_f32 v45, 1.0, v45
    v_rcp_f32 v45, v45
    s_nop 0
    v_mul_f32 v44, v44, v45

    v_cvt_pk_bf16_f32 v40, v43, v44
    v_lshlrev_b32 v43, 16, v40
    v_and_b32 v44, 0xffff0000, v40
    v_mul_f32 v41, v41, v43
    v_mul_f32 v42, v42, v44
    v_cvt_pk_bf16_f32 v40, v41, v42
    v_lshlrev_b32 v41, 16, v40
    v_and_b32 v42, 0xffff0000, v40
    v_lshlrev_b32 v45, 16, v65
    v_and_b32 v46, 0xffff0000, v65
    v_add_f32 v41, v41, v45
    v_add_f32 v42, v42, v46
    v_cvt_pk_bf16_f32 v69, v41, v42

    s_mov_b64 exec, 0xffff
    buffer_store_dwordx2 v[68:69], v6, s[76:79], s51 offen
    s_mov_b64 exec, -1
L_m_fin:

    s_branch L_end
L_service:
    s_mov_b32 s32, s18
    s_and_b32 s33, s19, 0xffff
    s_mov_b32 s34, 3584
    s_mov_b32 s35, 0x20000

    s_cmp_lt_u32 s2, 184
    s_cbranch_scc1 L_s_nozero
    s_sub_u32 s62, s2, 184
    s_cmp_ge_u32 s62, 8
    s_cbranch_scc1 L_s_nozero
    v_mov_b32 v8, 0
    v_lshlrev_b32 v7, 8, v1
    s_mov_b32 s55, 196608
    s_cmp_lg_u32 s62, 0
    s_cbranch_scc1 L_s_noz0
    buffer_store_dword v8, v7, s[40:43], s55 offen sc0 sc1
L_s_noz0:
    v_mov_b32 v8, -1
    v_mov_b32 v9, -1
    v_mov_b32 v10, -1
    v_mov_b32 v11, -1
    v_lshlrev_b32 v7, 4, v1
    s_lshl_b32 s55, s62, 13
    s_add_u32 s56, s55, 4096
    buffer_store_dwordx4 v[8:11], v7, s[40:43], s55 offen sc0 sc1
    buffer_store_dwordx4 v[8:11], v7, s[40:43], s55 offen offset:1024 sc0 sc1
    buffer_store_dwordx4 v[8:11], v7, s[40:43], s55 offen offset:2048 sc0 sc1
    buffer_store_dwordx4 v[8:11], v7, s[40:43], s55 offen offset:3072 sc0 sc1
    buffer_store_dwordx4 v[8:11], v7, s[40:43], s56 offen sc0 sc1
    buffer_store_dwordx4 v[8:11], v7, s[40:43], s56 offen offset:1024 sc0 sc1
    buffer_store_dwordx4 v[8:11], v7, s[40:43], s56 offen offset:2048 sc0 sc1
    buffer_store_dwordx4 v[8:11], v7, s[40:43], s56 offen offset:3072 sc0 sc1
    s_waitcnt vmcnt(0)
    v_mov_b32 v13, 252
    v_mov_b32 v12, 1
    s_mov_b64 exec, 1
    buffer_atomic_add v12, v13, s[44:47], 0 offen
    s_mov_b64 exec, -1
L_s_nozero:
    v_mov_b32 v8, -1
    v_mov_b32 v9, -1
    v_mov_b32 v10, -1
    v_mov_b32 v11, -1
    v_lshrrev_b32 v14, 3, v1
    v_and_b32 v15, 7, v1
    v_lshlrev_b32 v7, 4, v1
    s_lshl_b32 s55, s2, 11
    s_add_u32 s55, s55, 262144
    buffer_store_dwordx4 v[8:11], v7, s[40:43], s55 offen sc0 sc1
    buffer_store_dwordx4 v[8:11], v7, s[40:43], s55 offen offset:1024 sc0 sc1
    v_lshlrev_b32 v6, 3, v1
    s_lshl_b32 s55, s2, 5
    s_add_u32 s55, s55, 131072
    s_mov_b64 exec, 0xf
    buffer_store_dwordx2 v[8:9], v6, s[40:43], s55 offen sc0 sc1
    s_mov_b64 exec, -1
    s_and_b32 s54, s2, 7
    s_lshr_b32 s50, s2, 3
    s_lshl_b32 s55, s54, 8
    s_add_u32 s55, s55, s50
    s_lshl_b32 s55, s55, 8
    s_add_u32 s55, s55, 786432
    v_lshlrev_b32 v6, 13, v3
    v_lshl_add_u32 v6, v2, 4, v6
    buffer_store_dwordx4 v[8:11], v6, s[40:43], s55 offen sc0 sc1
    s_add_u32 s55, s55, 32768
    buffer_store_dwordx4 v[8:11], v6, s[40:43], s55 offen sc0 sc1
    s_cmp_lt_u32 s2, 144
    s_cbranch_scc1 L_s_noi2
    s_sub_u32 s51, s2, 144
    s_lshr_b32 s51, s51, 3
    s_lshl_b32 s55, s54, 7
    s_add_u32 s55, s55, s51
    s_lshl_b32 s55, s55, 8
    s_add_u32 s55, s55, 1310720
    v_lshlrev_b32 v6, 12, v3
    v_lshl_add_u32 v6, v2, 4, v6
    buffer_store_dwordx4 v[8:11], v6, s[40:43], s55 offen sc0 sc1
    s_add_u32 s55, s55, 16384
    buffer_store_dwordx4 v[8:11], v6, s[40:43], s55 offen sc0 sc1
L_s_noi2:
    s_cmp_ge_u32 s2, 184
    s_cbranch_scc1 L_s_noi3
    s_sub_u32 s61, s2, 128
    s_cmp_lt_u32 s2, 128
    s_cselect_b32 s61, s2, s61
    s_mov_b32 s52, 8192
    s_mov_b32 s53, 3584
    s_cselect_b32 s52, s52, s53
    s_cselect_b32 s53, 0, 65536
    s_lshl_b32 s55, s61, 6
    s_add_u32 s53, s53, s55
    v_mul_lo_u32 v6, v14, s52
    v_lshl_add_u32 v6, v15, 3, v6
    s_cmp_lt_u32 s2, 128
    s_cbranch_scc1 L_s_noi3
    buffer_store_dwordx2 v[8:9], v6, s[40:43], s53 offen sc0 sc1
    v_lshlrev_b32 v10, 3, v15
    buffer_load_dwordx2 v[22:23], v10, s[32:35], s55 offen
L_s_noi3:
    s_barrier
    v_mov_b32 v13, 252
    s_mov_b32 s63, 2000000
L_s_pz:
    buffer_load_dword v12, v13, s[44:47], 0 offen sc0 sc1
    s_waitcnt vmcnt(0)
    v_readfirstlane_b32 s55, v12
    s_cmp_ge_u32 s55, 8
    s_cbranch_scc1 L_s_pzd
    s_sleep 1
    s_sub_u32 s63, s63, 1
    s_cmp_lg_u32 s63, 0
    s_cbranch_scc1 L_s_pz
L_s_pzd:
    s_and_b32 s56, s2, 15
    s_lshl_b32 s56, s56, 8
    s_add_u32 s56, s56, 200704
    v_mov_b32 v12, 1
    v_mov_b32 v13, s56
    s_mov_b64 exec, 1
    buffer_atomic_add v12, v13, s[40:43], 0 offen
    s_mov_b64 exec, -1
    s_barrier

    s_cmp_ge_u32 s2, 184
    s_cbranch_scc1 L_s_nop1

    ds_read_b128 v[24:27], v7 offset:8448
    ds_read_b128 v[28:31], v7 offset:9472
    ds_read_b128 v[32:35], v7 offset:10496
    ds_read_b128 v[36:39], v7 offset:11520
    ds_read_b128 v[40:43], v7 offset:12544
    ds_read_b128 v[44:47], v7 offset:13568
    ds_read_b128 v[48:51], v7 offset:14592
    ds_read_b128 v[52:55], v7 offset:15616
    s_waitcnt lgkmcnt(0)
    v_add_f32 v24, v24, v28
    v_add_f32 v25, v25, v29
    v_add_f32 v26, v26, v30
    v_add_f32 v27, v27, v31
    v_add_f32 v24, v24, v32
    v_add_f32 v25, v25, v33
    v_add_f32 v26, v26, v34
    v_add_f32 v27, v27, v35
    v_add_f32 v24, v24, v36
    v_add_f32 v25, v25, v37
    v_add_f32 v26, v26, v38
    v_add_f32 v27, v27, v39
    v_add_f32 v24, v24, v40
    v_add_f32 v25, v25, v41
    v_add_f32 v26, v26, v42
    v_add_f32 v27, v27, v43
    v_add_f32 v24, v24, v44
    v_add_f32 v25, v25, v45
    v_add_f32 v26, v26, v46
    v_add_f32 v27, v27, v47
    v_add_f32 v24, v24, v48
    v_add_f32 v25, v25, v49
    v_add_f32 v26, v26, v50
    v_add_f32 v27, v27, v51
    v_add_f32 v24, v24, v52
    v_add_f32 v25, v25, v53
    v_add_f32 v26, v26, v54
    v_add_f32 v27, v27, v55
    v_cvt_pk_bf16_f32 v20, v24, v25
    v_cvt_pk_bf16_f32 v21, v26, v27
    s_cmp_lt_u32 s2, 128
    s_cbranch_scc1 L_s_pub
    s_waitcnt vmcnt(0)
    v_lshlrev_b32 v16, 16, v20
    v_and_b32 v17, 0xffff0000, v20
    v_lshlrev_b32 v18, 16, v21
    v_and_b32 v19, 0xffff0000, v21
    v_lshlrev_b32 v24, 16, v22
    v_and_b32 v25, 0xffff0000, v22
    v_lshlrev_b32 v26, 16, v23
    v_and_b32 v27, 0xffff0000, v23
    v_add_f32 v16, v16, v24
    v_add_f32 v17, v17, v25
    v_add_f32 v18, v18, v26
    v_add_f32 v19, v19, v27
    v_cvt_pk_bf16_f32 v20, v16, v17
    v_cvt_pk_bf16_f32 v21, v18, v19
    v_lshlrev_b32 v16, 16, v20
    v_and_b32 v17, 0xffff0000, v20
    v_lshlrev_b32 v18, 16, v21
    v_and_b32 v19, 0xffff0000, v21

    v_mul_f32 v24, v16, v16
    v_mul_f32 v24, 0xbdd2d3e8, v24
    v_add_f32 v24, 0xc0135761, v24
    v_mul_f32 v24, v24, v16
    v_exp_f32 v24, v24
    s_nop 0
    v_add_f32 v24, 1.0, v24
    v_rcp_f32 v24, v24
    s_nop 0
    v_mul_f32 v16, v16, v24

    v_mul_f32 v24, v17, v17
    v_mul_f32 v24, 0xbdd2d3e8, v24
    v_add_f32 v24, 0xc0135761, v24
    v_mul_f32 v24, v24, v17
    v_exp_f32 v24, v24
    s_nop 0
    v_add_f32 v24, 1.0, v24
    v_rcp_f32 v24, v24
    s_nop 0
    v_mul_f32 v17, v17, v24

    v_mul_f32 v24, v18, v18
    v_mul_f32 v24, 0xbdd2d3e8, v24
    v_add_f32 v24, 0xc0135761, v24
    v_mul_f32 v24, v24, v18
    v_exp_f32 v24, v24
    s_nop 0
    v_add_f32 v24, 1.0, v24
    v_rcp_f32 v24, v24
    s_nop 0
    v_mul_f32 v18, v18, v24

    v_mul_f32 v24, v19, v19
    v_mul_f32 v24, 0xbdd2d3e8, v24
    v_add_f32 v24, 0xc0135761, v24
    v_mul_f32 v24, v24, v19
    v_exp_f32 v24, v24
    s_nop 0
    v_add_f32 v24, 1.0, v24
    v_rcp_f32 v24, v24
    s_nop 0
    v_mul_f32 v19, v19, v24

    v_cvt_pk_bf16_f32 v20, v16, v17
    v_cvt_pk_bf16_f32 v21, v18, v19
L_s_pub:
    buffer_store_dwordx2 v[20:21], v6, s[40:43], s53 offen sc0 sc1
L_s_nop1:

    s_lshr_b32 s55, s2, 2
    s_lshl_b32 s60, s55, 10

    v_lshlrev_b32 v13, 8, v2
    v_add_u32 v13, 200704, v13
    s_mov_b32 s63, 2000000
L_pd_q:
    buffer_load_dwordx4 v[16:19], v7, s[40:43], s60 offen sc0 sc1
    s_waitcnt vmcnt(0)
    v_max_u32 v12, v16, v17
    v_max3_u32 v12, v12, v18, v19
    v_cmp_eq_u32 vcc, -1, v12
    s_cmp_eq_u64 vcc, 0
    s_cbranch_scc1 L_pdd_q
    s_sleep 1
    s_sub_u32 s63, s63, 1
    s_cmp_lg_u32 s63, 0
    s_cbranch_scc1 L_pd_q
L_pdd_q:

    ds_write_b128 v7, v[16:19] offset:16640
    s_waitcnt lgkmcnt(0)

    s_barrier
L_end:
    s_endpgm
.section .rodata,"a"
.p2align 6
.amdhsa_kernel recurrent_scan__sliding_block_cached__dense_activation_gelu__decode_kernel
  .amdhsa_next_free_vgpr 168
  .amdhsa_next_free_sgpr 102
  .amdhsa_accum_offset 168
  .amdhsa_group_segment_fixed_size 0
  .amdhsa_kernarg_size 104
  .amdhsa_user_sgpr_count 2
  .amdhsa_user_sgpr_kernarg_segment_ptr 1
  .amdhsa_system_sgpr_workgroup_id_x 1
.end_amdhsa_kernel
.text
```
